```python
import torch

def _softmax(x, axis=-1):
    return torch.softmax(x, dim=axis)
def _gelu(x):
    return torch.nn.functional.gelu(x, approximate="tanh")
def _silu(x):
    return torch.nn.functional.silu(x)
def _sigmoid(x):
    return torch.sigmoid(x)
def _layernorm(x, axis=-1, eps=1e-5):
    m = x.mean(dim=axis, keepdim=True)
    v = x.var(dim=axis, keepdim=True, unbiased=False)
    return (x - m) / torch.sqrt(v + eps)
def _scatter_add(tgt, idx, src, axis=0):
    return tgt.clone().index_add_(axis, idx, src)
def _segment_sum(src, seg, n):
    out = torch.zeros((n,) + src.shape[1:], dtype=src.dtype)
    return out.index_add_(0, seg, src)
def _pad(x, pw):
    flat = tuple(v for pair in reversed(pw) for v in pair)
    return torch.nn.functional.pad(x, flat)

kernel_name = 'standalone__attention_interact_autoint__recsys'

def setup_inputs():

    _w = (lambda a: (lambda t: t.to(torch.bfloat16) if t.is_floating_point() else t)(torch.as_tensor(a)))
    B, F = 4096, 26
    D = max(2, (128 // 2) * 2)
    H = 2
    Dh = D // H
    return {
        "e": _w((lambda *s: torch.randn(*s, dtype=torch.bfloat16) * 0.05)(B, F, D).to(float)),
        "wq": _w((lambda *s: torch.randn(*s, dtype=torch.bfloat16) * 1.6)(H, D, Dh).to(float)),
        "wk": _w((lambda *s: torch.randn(*s, dtype=torch.bfloat16) * 1.6)(H, D, Dh).to(float)),
        "wv": _w((lambda *s: torch.randn(*s, dtype=torch.bfloat16) * 0.05)(H, D, Dh).to(float)),
        "wres": _w((lambda *s: torch.randn(*s, dtype=torch.bfloat16) * 0.05)(D, D).to(float)),
    }

def reference(e, wq, wk, wv, wres):
    H, D, Dh = wq.shape[0], wq.shape[1], wq.shape[2]
    B, F = e.shape[0], e.shape[1]
    q = torch.einsum('bfd,hdk->bhfk', e, wq)
    k = torch.einsum('bfd,hdk->bhfk', e, wk)
    v = torch.einsum('bfd,hdk->bhfk', e, wv)
    scale = float(Dh) ** -0.5
    scores = torch.einsum('bhfk,bhgk->bhfg', q, k) * scale
    attn = _softmax(scores, axis=-1)
    attn = (lambda x, dt: x.to(dt))(attn, v.dtype)
    ctx = torch.einsum('bhfg,bhgk->bhfk', attn, v)
    ctx = (lambda x, *d: x.permute(*d))(ctx, 0, 2, 1, 3).reshape(B, F, H * Dh)
    res = torch.einsum('bfd,de->bfe', e, wres)
    out = ctx + res
    mask = (lambda x, dt: x.to(dt))(out > 0, out.dtype)
    return out * mask
```

```asm
; @launch grid=(256,1,1) block=(256,1,1) lds=131072
.amdgcn_target "amdgcn-amd-amdhsa--gfx950"
.text
.globl standalone__attention_interact_autoint__recsys_kernel
.p2align 8
.type standalone__attention_interact_autoint__recsys_kernel,@function
standalone__attention_interact_autoint__recsys_kernel:
    s_cmp_ge_u32 s2, 256
    s_cbranch_scc1 L_done
    s_load_dwordx8 s[28:35], s[0:1], 0
    s_load_dwordx4 s[36:39], s[0:1], 32
    v_lshlrev_b32 v241, 4, v0
    v_lshrrev_b32 v2, 6, v0
    s_nop 0
    v_readfirstlane_b32 s43, v2
    s_waitcnt lgkmcnt(0)
    s_mov_b32 s8, s28
    s_and_b32 s9, s29, 0xffff
    s_mov_b32 s10, 27262976
    s_mov_b32 s11, 0x20000
    s_mov_b32 s24, s38
    s_and_b32 s25, s39, 0xffff
    s_mov_b32 s26, 27262976
    s_mov_b32 s27, 0x20000
    s_mov_b32 s12, s30
    s_and_b32 s13, s31, 0xffff
    s_mov_b32 s14, 32768
    s_mov_b32 s15, 0x20000
    s_mov_b32 s16, s32
    s_and_b32 s17, s33, 0xffff
    s_mov_b32 s18, 32768
    s_mov_b32 s19, 0x20000
    s_mov_b32 s20, s34
    s_and_b32 s21, s35, 0xffff
    s_mov_b32 s22, 32768
    s_mov_b32 s23, 0x20000
    s_mov_b32 s44, s36
    s_and_b32 s45, s37, 0xffff
    s_mov_b32 s46, 32768
    s_mov_b32 s47, 0x20000
    s_mov_b32 s61, 4096
    s_mov_b32 s62, 8192
    s_mov_b32 s63, 12288
    s_mov_b32 s64, 16384
    s_mov_b32 s65, 20480
    s_mov_b32 s66, 24576
    s_mov_b32 s67, 28672
    buffer_load_dwordx4 v[64:67], v241, s[12:15], 0 offen offset:0
    buffer_load_dwordx4 v[68:71], v241, s[12:15], s61 offen
    buffer_load_dwordx4 v[72:75], v241, s[12:15], s62 offen
    buffer_load_dwordx4 v[76:79], v241, s[12:15], s63 offen
    buffer_load_dwordx4 v[80:83], v241, s[12:15], s64 offen
    buffer_load_dwordx4 v[84:87], v241, s[12:15], s65 offen
    buffer_load_dwordx4 v[88:91], v241, s[12:15], s66 offen
    buffer_load_dwordx4 v[92:95], v241, s[12:15], s67 offen
    buffer_load_dwordx4 v[96:99], v241, s[16:19], 0 offen offset:0
    buffer_load_dwordx4 v[100:103], v241, s[16:19], s61 offen
    buffer_load_dwordx4 v[104:107], v241, s[16:19], s62 offen
    buffer_load_dwordx4 v[108:111], v241, s[16:19], s63 offen
    buffer_load_dwordx4 v[112:115], v241, s[16:19], s64 offen
    buffer_load_dwordx4 v[116:119], v241, s[16:19], s65 offen
    buffer_load_dwordx4 v[120:123], v241, s[16:19], s66 offen
    buffer_load_dwordx4 v[124:127], v241, s[16:19], s67 offen
    buffer_load_dwordx4 v[128:131], v241, s[20:23], 0 offen offset:0
    buffer_load_dwordx4 v[132:135], v241, s[20:23], s61 offen
    buffer_load_dwordx4 v[136:139], v241, s[20:23], s62 offen
    buffer_load_dwordx4 v[140:143], v241, s[20:23], s63 offen
    buffer_load_dwordx4 v[144:147], v241, s[20:23], s64 offen
    buffer_load_dwordx4 v[148:151], v241, s[20:23], s65 offen
    buffer_load_dwordx4 v[152:155], v241, s[20:23], s66 offen
    buffer_load_dwordx4 v[156:159], v241, s[20:23], s67 offen
    buffer_load_dwordx4 v[160:163], v241, s[44:47], 0 offen offset:0
    buffer_load_dwordx4 v[164:167], v241, s[44:47], s61 offen
    buffer_load_dwordx4 v[168:171], v241, s[44:47], s62 offen
    buffer_load_dwordx4 v[172:175], v241, s[44:47], s63 offen
    buffer_load_dwordx4 v[176:179], v241, s[44:47], s64 offen
    buffer_load_dwordx4 v[180:183], v241, s[44:47], s65 offen
    buffer_load_dwordx4 v[184:187], v241, s[44:47], s66 offen
    buffer_load_dwordx4 v[188:191], v241, s[44:47], s67 offen
    s_lshr_b32 s4, s43, 1
    s_and_b32 s5, s43, 1
    s_lshl_b32 s6, s2, 1
    s_add_u32 s6, s6, s4
    s_mul_i32 s6, s6, 53248
    s_mov_b32 s50, s6
    s_add_u32 s51, s6, 6656
    s_mov_b32 s52, 0x40000000
    s_mov_b32 s53, 4
    v_and_b32 v242, 63, v0
    v_and_b32 v243, 31, v242
    v_lshrrev_b32 v244, 5, v242
    v_lshlrev_b32 v245, 8, v243
    v_lshl_add_u32 v232, v244, 4, v245
    s_lshl_b32 s7, s5, 7
    v_add_u32 v233, s7, v232
    v_mov_b32 v246, 0x40000000
    v_cmp_gt_u32 vcc, 26, v243
    s_nop 1
    v_cndmask_b32 v233, v246, v233, vcc
    v_mov_b32 v234, 0xff800000
    v_mov_b32 v215, 0
    s_mov_b32 s40, 0
    s_mov_b32 s41, -1
    s_mov_b32 s42, 0x3e38aa3b
    v_bfe_u32 v247, v0, 4, 1
    v_lshlrev_b32 v247, 6, v247
    v_xor_b32 v247, v247, v241
    v_add_u32 v248, 0x10000, v247
    v_bfe_u32 v249, v0, 4, 2
    v_lshlrev_b32 v249, 6, v249
    v_xor_b32 v249, v249, v241
    v_add_u32 v249, 0x18000, v249
    buffer_load_dwordx4 v[0:3], v232, s[8:11], s50 offen offset:0
    buffer_load_dwordx4 v[4:7], v232, s[8:11], s50 offen offset:32
    buffer_load_dwordx4 v[8:11], v232, s[8:11], s50 offen offset:64
    buffer_load_dwordx4 v[12:15], v232, s[8:11], s50 offen offset:96
    buffer_load_dwordx4 v[16:19], v232, s[8:11], s50 offen offset:128
    buffer_load_dwordx4 v[20:23], v232, s[8:11], s50 offen offset:160
    buffer_load_dwordx4 v[24:27], v232, s[8:11], s50 offen offset:192
    buffer_load_dwordx4 v[28:31], v232, s[8:11], s50 offen offset:224
    s_waitcnt vmcnt(32)
    ds_write_b128 v247, v[64:67] offset:0
    ds_write_b128 v247, v[68:71] offset:4096
    ds_write_b128 v247, v[72:75] offset:8192
    ds_write_b128 v247, v[76:79] offset:12288
    ds_write_b128 v247, v[80:83] offset:16384
    ds_write_b128 v247, v[84:87] offset:20480
    ds_write_b128 v247, v[88:91] offset:24576
    ds_write_b128 v247, v[92:95] offset:28672
    s_waitcnt vmcnt(24)
    ds_write_b128 v247, v[96:99] offset:32768
    ds_write_b128 v247, v[100:103] offset:36864
    ds_write_b128 v247, v[104:107] offset:40960
    ds_write_b128 v247, v[108:111] offset:45056
    ds_write_b128 v247, v[112:115] offset:49152
    ds_write_b128 v247, v[116:119] offset:53248
    ds_write_b128 v247, v[120:123] offset:57344
    ds_write_b128 v247, v[124:127] offset:61440
    s_waitcnt vmcnt(16)
    ds_write_b128 v248, v[128:131] offset:0
    ds_write_b128 v248, v[132:135] offset:4096
    ds_write_b128 v248, v[136:139] offset:8192
    ds_write_b128 v248, v[140:143] offset:12288
    ds_write_b128 v248, v[144:147] offset:16384
    ds_write_b128 v248, v[148:151] offset:20480
    ds_write_b128 v248, v[152:155] offset:24576
    ds_write_b128 v248, v[156:159] offset:28672
    s_waitcnt vmcnt(8)
    ds_write_b128 v249, v[160:163] offset:0
    ds_write_b128 v249, v[164:167] offset:4096
    ds_write_b128 v249, v[168:171] offset:8192
    ds_write_b128 v249, v[172:175] offset:12288
    ds_write_b128 v249, v[176:179] offset:16384
    ds_write_b128 v249, v[180:183] offset:20480
    ds_write_b128 v249, v[184:187] offset:24576
    ds_write_b128 v249, v[188:191] offset:28672
    v_lshrrev_b32 v225, 4, v242
    v_and_b32 v226, 1, v225
    v_lshrrev_b32 v225, 1, v225
    v_bfe_u32 v227, v242, 2, 2
    v_and_b32 v228, 3, v242
    v_lshl_add_u32 v229, v225, 3, v227
    v_lshlrev_b32 v228, 3, v228
    v_lshl_add_u32 v228, v226, 5, v228
    v_lshl_add_u32 v230, v229, 7, v228
    s_lshl_b32 s7, s5, 14
    v_add_u32 v230, s7, v230
    v_lshrrev_b32 v231, 1, v227
    v_lshlrev_b32 v231, 6, v231
    v_xor_b32 v216, v230, v231
    v_xor_b32 v217, 64, v216
    v_add_u32 v218, 0x10000, v216
    v_add_u32 v219, 0x10000, v217
    v_lshl_add_u32 v230, v229, 8, v228
    s_lshl_b32 s7, s5, 7
    s_add_u32 s7, s7, 0x18000
    v_add_u32 v230, s7, v230
    v_lshlrev_b32 v231, 6, v227
    v_xor_b32 v220, v230, v231
    v_xor_b32 v221, 64, v220
    s_waitcnt lgkmcnt(0)
    s_barrier
    ds_read_b64_tr_b16 a[0:1], v216 offset:0
    ds_read_b64_tr_b16 a[2:3], v216 offset:512
    ds_read_b64_tr_b16 a[4:5], v216 offset:2048
    ds_read_b64_tr_b16 a[6:7], v216 offset:2560
    ds_read_b64_tr_b16 a[8:9], v216 offset:4096
    ds_read_b64_tr_b16 a[10:11], v216 offset:4608
    ds_read_b64_tr_b16 a[12:13], v216 offset:6144
    ds_read_b64_tr_b16 a[14:15], v216 offset:6656
    ds_read_b64_tr_b16 a[16:17], v216 offset:8192
    ds_read_b64_tr_b16 a[18:19], v216 offset:8704
    ds_read_b64_tr_b16 a[20:21], v216 offset:10240
    ds_read_b64_tr_b16 a[22:23], v216 offset:10752
    ds_read_b64_tr_b16 a[24:25], v216 offset:12288
    ds_read_b64_tr_b16 a[26:27], v216 offset:12800
    ds_read_b64_tr_b16 a[28:29], v216 offset:14336
    ds_read_b64_tr_b16 a[30:31], v216 offset:14848
    ds_read_b64_tr_b16 a[32:33], v217 offset:0
    ds_read_b64_tr_b16 a[34:35], v217 offset:512
    ds_read_b64_tr_b16 a[36:37], v217 offset:2048
    ds_read_b64_tr_b16 a[38:39], v217 offset:2560
    ds_read_b64_tr_b16 a[40:41], v217 offset:4096
    ds_read_b64_tr_b16 a[42:43], v217 offset:4608
    ds_read_b64_tr_b16 a[44:45], v217 offset:6144
    ds_read_b64_tr_b16 a[46:47], v217 offset:6656
    ds_read_b64_tr_b16 a[48:49], v217 offset:8192
    ds_read_b64_tr_b16 a[50:51], v217 offset:8704
    ds_read_b64_tr_b16 a[52:53], v217 offset:10240
    ds_read_b64_tr_b16 a[54:55], v217 offset:10752
    ds_read_b64_tr_b16 a[56:57], v217 offset:12288
    ds_read_b64_tr_b16 a[58:59], v217 offset:12800
    ds_read_b64_tr_b16 a[60:61], v217 offset:14336
    ds_read_b64_tr_b16 a[62:63], v217 offset:14848
    ds_read_b64_tr_b16 a[64:65], v216 offset:32768
    ds_read_b64_tr_b16 a[66:67], v216 offset:33280
    ds_read_b64_tr_b16 a[68:69], v216 offset:34816
    ds_read_b64_tr_b16 a[70:71], v216 offset:35328
    ds_read_b64_tr_b16 a[72:73], v216 offset:36864
    ds_read_b64_tr_b16 a[74:75], v216 offset:37376
    ds_read_b64_tr_b16 a[76:77], v216 offset:38912
    ds_read_b64_tr_b16 a[78:79], v216 offset:39424
    ds_read_b64_tr_b16 a[80:81], v216 offset:40960
    ds_read_b64_tr_b16 a[82:83], v216 offset:41472
    ds_read_b64_tr_b16 a[84:85], v216 offset:43008
    ds_read_b64_tr_b16 a[86:87], v216 offset:43520
    ds_read_b64_tr_b16 a[88:89], v216 offset:45056
    ds_read_b64_tr_b16 a[90:91], v216 offset:45568
    ds_read_b64_tr_b16 a[92:93], v216 offset:47104
    ds_read_b64_tr_b16 a[94:95], v216 offset:47616
    ds_read_b64_tr_b16 a[96:97], v217 offset:32768
    ds_read_b64_tr_b16 a[98:99], v217 offset:33280
    ds_read_b64_tr_b16 a[100:101], v217 offset:34816
    ds_read_b64_tr_b16 a[102:103], v217 offset:35328
    ds_read_b64_tr_b16 a[104:105], v217 offset:36864
    ds_read_b64_tr_b16 a[106:107], v217 offset:37376
    ds_read_b64_tr_b16 a[108:109], v217 offset:38912
    ds_read_b64_tr_b16 a[110:111], v217 offset:39424
    ds_read_b64_tr_b16 a[112:113], v217 offset:40960
    ds_read_b64_tr_b16 a[114:115], v217 offset:41472
    ds_read_b64_tr_b16 a[116:117], v217 offset:43008
    ds_read_b64_tr_b16 a[118:119], v217 offset:43520
    ds_read_b64_tr_b16 a[120:121], v217 offset:45056
    ds_read_b64_tr_b16 a[122:123], v217 offset:45568
    ds_read_b64_tr_b16 a[124:125], v217 offset:47104
    ds_read_b64_tr_b16 a[126:127], v217 offset:47616
    ds_read_b64_tr_b16 a[128:129], v218 offset:0
    ds_read_b64_tr_b16 a[130:131], v218 offset:512
    ds_read_b64_tr_b16 a[132:133], v218 offset:2048
    ds_read_b64_tr_b16 a[134:135], v218 offset:2560
    ds_read_b64_tr_b16 a[136:137], v218 offset:4096
    ds_read_b64_tr_b16 a[138:139], v218 offset:4608
    ds_read_b64_tr_b16 a[140:141], v218 offset:6144
    ds_read_b64_tr_b16 a[142:143], v218 offset:6656
    ds_read_b64_tr_b16 a[144:145], v218 offset:8192
    ds_read_b64_tr_b16 a[146:147], v218 offset:8704
    ds_read_b64_tr_b16 a[148:149], v218 offset:10240
    ds_read_b64_tr_b16 a[150:151], v218 offset:10752
    ds_read_b64_tr_b16 a[152:153], v218 offset:12288
    ds_read_b64_tr_b16 a[154:155], v218 offset:12800
    ds_read_b64_tr_b16 a[156:157], v218 offset:14336
    ds_read_b64_tr_b16 a[158:159], v218 offset:14848
    ds_read_b64_tr_b16 a[160:161], v219 offset:0
    ds_read_b64_tr_b16 a[162:163], v219 offset:512
    ds_read_b64_tr_b16 a[164:165], v219 offset:2048
    ds_read_b64_tr_b16 a[166:167], v219 offset:2560
    ds_read_b64_tr_b16 a[168:169], v219 offset:4096
    ds_read_b64_tr_b16 a[170:171], v219 offset:4608
    ds_read_b64_tr_b16 a[172:173], v219 offset:6144
    ds_read_b64_tr_b16 a[174:175], v219 offset:6656
    ds_read_b64_tr_b16 a[176:177], v219 offset:8192
    ds_read_b64_tr_b16 a[178:179], v219 offset:8704
    ds_read_b64_tr_b16 a[180:181], v219 offset:10240
    ds_read_b64_tr_b16 a[182:183], v219 offset:10752
    ds_read_b64_tr_b16 a[184:185], v219 offset:12288
    ds_read_b64_tr_b16 a[186:187], v219 offset:12800
    ds_read_b64_tr_b16 a[188:189], v219 offset:14336
    ds_read_b64_tr_b16 a[190:191], v219 offset:14848
    ds_read_b64_tr_b16 a[192:193], v220 offset:0
    ds_read_b64_tr_b16 a[194:195], v220 offset:1024
    ds_read_b64_tr_b16 a[196:197], v220 offset:4096
    ds_read_b64_tr_b16 a[198:199], v220 offset:5120
    ds_read_b64_tr_b16 a[200:201], v220 offset:8192
    ds_read_b64_tr_b16 a[202:203], v220 offset:9216
    ds_read_b64_tr_b16 a[204:205], v220 offset:12288
    ds_read_b64_tr_b16 a[206:207], v220 offset:13312
    ds_read_b64_tr_b16 a[208:209], v220 offset:16384
    ds_read_b64_tr_b16 a[210:211], v220 offset:17408
    ds_read_b64_tr_b16 a[212:213], v220 offset:20480
    ds_read_b64_tr_b16 a[214:215], v220 offset:21504
    ds_read_b64_tr_b16 a[216:217], v220 offset:24576
    ds_read_b64_tr_b16 a[218:219], v220 offset:25600
    ds_read_b64_tr_b16 a[220:221], v220 offset:28672
    ds_read_b64_tr_b16 a[222:223], v220 offset:29696
    ds_read_b64_tr_b16 a[224:225], v221 offset:0
    ds_read_b64_tr_b16 a[226:227], v221 offset:1024
    ds_read_b64_tr_b16 a[228:229], v221 offset:4096
    ds_read_b64_tr_b16 a[230:231], v221 offset:5120
    ds_read_b64_tr_b16 a[232:233], v221 offset:8192
    ds_read_b64_tr_b16 a[234:235], v221 offset:9216
    ds_read_b64_tr_b16 a[236:237], v221 offset:12288
    ds_read_b64_tr_b16 a[238:239], v221 offset:13312
    ds_read_b64_tr_b16 a[240:241], v221 offset:16384
    ds_read_b64_tr_b16 a[242:243], v221 offset:17408
    ds_read_b64_tr_b16 a[244:245], v221 offset:20480
    ds_read_b64_tr_b16 a[246:247], v221 offset:21504
    ds_read_b64_tr_b16 a[248:249], v221 offset:24576
    ds_read_b64_tr_b16 a[250:251], v221 offset:25600
    ds_read_b64_tr_b16 a[252:253], v221 offset:28672
    ds_read_b64_tr_b16 a[254:255], v221 offset:29696
    s_waitcnt vmcnt(0) lgkmcnt(0)
    v_mfma_f32_32x32x16_bf16 v[64:79], a[0:3], v[0:3], 0
    v_mfma_f32_32x32x16_bf16 v[64:79], a[4:7], v[4:7], v[64:79]
    v_mfma_f32_32x32x16_bf16 v[64:79], a[8:11], v[8:11], v[64:79]
    v_mfma_f32_32x32x16_bf16 v[64:79], a[12:15], v[12:15], v[64:79]
    v_mfma_f32_32x32x16_bf16 v[64:79], a[16:19], v[16:19], v[64:79]
    v_mfma_f32_32x32x16_bf16 v[64:79], a[20:23], v[20:23], v[64:79]
    v_mfma_f32_32x32x16_bf16 v[64:79], a[24:27], v[24:27], v[64:79]
    v_mfma_f32_32x32x16_bf16 v[64:79], a[28:31], v[28:31], v[64:79]
    v_mfma_f32_32x32x16_bf16 v[80:95], a[32:35], v[0:3], 0
    v_mfma_f32_32x32x16_bf16 v[80:95], a[36:39], v[4:7], v[80:95]
    v_mfma_f32_32x32x16_bf16 v[80:95], a[40:43], v[8:11], v[80:95]
    v_mfma_f32_32x32x16_bf16 v[80:95], a[44:47], v[12:15], v[80:95]
    v_mfma_f32_32x32x16_bf16 v[80:95], a[48:51], v[16:19], v[80:95]
    v_mfma_f32_32x32x16_bf16 v[80:95], a[52:55], v[20:23], v[80:95]
    v_mfma_f32_32x32x16_bf16 v[80:95], a[56:59], v[24:27], v[80:95]
    v_mfma_f32_32x32x16_bf16 v[80:95], a[60:63], v[28:31], v[80:95]
    s_nop 7
    L_loop:
    v_mfma_f32_32x32x16_bf16 v[96:111], a[64:67], v[0:3], 0
    v_mfma_f32_32x32x16_bf16 v[96:111], a[68:71], v[4:7], v[96:111]
    v_mfma_f32_32x32x16_bf16 v[96:111], a[72:75], v[8:11], v[96:111]
    buffer_load_dwordx4 v[32:35], v232, s[8:11], s51 offen offset:0
    buffer_load_dwordx4 v[36:39], v232, s[8:11], s51 offen offset:32
    buffer_load_dwordx4 v[40:43], v232, s[8:11], s51 offen offset:64
    buffer_load_dwordx4 v[44:47], v232, s[8:11], s51 offen offset:96
    buffer_load_dwordx4 v[48:51], v232, s[8:11], s51 offen offset:128
    v_mfma_f32_32x32x16_bf16 v[96:111], a[76:79], v[12:15], v[96:111]
    buffer_load_dwordx4 v[52:55], v232, s[8:11], s51 offen offset:160
    buffer_load_dwordx4 v[56:59], v232, s[8:11], s51 offen offset:192
    buffer_load_dwordx4 v[60:63], v232, s[8:11], s51 offen offset:224
    v_cvt_pk_bf16_f32 v160, v64, v65
    v_cvt_pk_bf16_f32 v161, v66, v67
    v_mfma_f32_32x32x16_bf16 v[96:111], a[80:83], v[16:19], v[96:111]
    v_cvt_pk_bf16_f32 v162, v68, v69
    v_cvt_pk_bf16_f32 v163, v70, v71
    v_cvt_pk_bf16_f32 v164, v72, v73
    v_cvt_pk_bf16_f32 v165, v74, v75
    v_cvt_pk_bf16_f32 v166, v76, v77
    v_mfma_f32_32x32x16_bf16 v[96:111], a[84:87], v[20:23], v[96:111]
    v_cvt_pk_bf16_f32 v167, v78, v79
    v_cvt_pk_bf16_f32 v168, v80, v81
    v_cvt_pk_bf16_f32 v169, v82, v83
    v_cvt_pk_bf16_f32 v170, v84, v85
    v_cvt_pk_bf16_f32 v171, v86, v87
    v_mfma_f32_32x32x16_bf16 v[96:111], a[88:91], v[24:27], v[96:111]
    v_cvt_pk_bf16_f32 v172, v88, v89
    v_cvt_pk_bf16_f32 v173, v90, v91
    v_cvt_pk_bf16_f32 v174, v92, v93
    v_cvt_pk_bf16_f32 v175, v94, v95
    v_cvt_pk_bf16_f32 v216, v128, v129
    v_mfma_f32_32x32x16_bf16 v[96:111], a[92:95], v[28:31], v[96:111]
    v_cvt_pk_bf16_f32 v217, v130, v131
    v_cvt_pk_bf16_f32 v218, v132, v133
    v_cvt_pk_bf16_f32 v219, v134, v135
    v_cvt_pk_bf16_f32 v220, v136, v137
    v_cvt_pk_bf16_f32 v221, v138, v139
    v_mfma_f32_32x32x16_bf16 v[112:127], a[96:99], v[0:3], 0
    v_cvt_pk_bf16_f32 v222, v140, v141
    v_cvt_pk_bf16_f32 v223, v142, v143
    v_cvt_pk_bf16_f32 v224, v144, v145
    v_cvt_pk_bf16_f32 v225, v146, v147
    v_cvt_pk_bf16_f32 v226, v148, v149
    v_mfma_f32_32x32x16_bf16 v[112:127], a[100:103], v[4:7], v[112:127]
    v_cvt_pk_bf16_f32 v227, v150, v151
    v_cvt_pk_bf16_f32 v228, v152, v153
    v_cvt_pk_bf16_f32 v229, v154, v155
    v_cvt_pk_bf16_f32 v230, v156, v157
    v_cvt_pk_bf16_f32 v231, v158, v159
    v_mfma_f32_32x32x16_bf16 v[112:127], a[104:107], v[8:11], v[112:127]
    v_pk_max_i16 v216, v216, 0
    v_pk_max_i16 v217, v217, 0
    v_pk_max_i16 v218, v218, 0
    v_pk_max_i16 v219, v219, 0
    v_pk_max_i16 v220, v220, 0
    v_mfma_f32_32x32x16_bf16 v[112:127], a[108:111], v[12:15], v[112:127]
    v_pk_max_i16 v221, v221, 0
    v_pk_max_i16 v222, v222, 0
    v_pk_max_i16 v223, v223, 0
    v_pk_max_i16 v224, v224, 0
    v_pk_max_i16 v225, v225, 0
    v_mfma_f32_32x32x16_bf16 v[112:127], a[112:115], v[16:19], v[112:127]
    v_pk_max_i16 v226, v226, 0
    v_pk_max_i16 v227, v227, 0
    v_pk_max_i16 v228, v228, 0
    v_pk_max_i16 v229, v229, 0
    v_pk_max_i16 v230, v230, 0
    v_mfma_f32_32x32x16_bf16 v[112:127], a[116:119], v[20:23], v[112:127]
    v_pk_max_i16 v231, v231, 0
    v_permlane32_swap_b32 v216, v218
    v_permlane32_swap_b32 v217, v219
    buffer_store_dwordx4 v[216:219], v233, s[24:27], s52 offen offset:0
    v_permlane32_swap_b32 v220, v222
    v_mfma_f32_32x32x16_bf16 v[112:127], a[120:123], v[24:27], v[112:127]
    v_permlane32_swap_b32 v221, v223
    buffer_store_dwordx4 v[220:223], v233, s[24:27], s52 offen offset:32
    v_permlane32_swap_b32 v224, v226
    v_permlane32_swap_b32 v225, v227
    buffer_store_dwordx4 v[224:227], v233, s[24:27], s52 offen offset:64
    v_mfma_f32_32x32x16_bf16 v[112:127], a[124:127], v[28:31], v[112:127]
    v_permlane32_swap_b32 v228, v230
    v_permlane32_swap_b32 v229, v231
    buffer_store_dwordx4 v[228:231], v233, s[24:27], s52 offen offset:96
    v_mfma_f32_32x32x16_bf16 v[64:79], v[0:3], a[128:131], 0
    v_mfma_f32_32x32x16_bf16 v[64:79], v[4:7], a[132:135], v[64:79]
    v_mfma_f32_32x32x16_bf16 v[64:79], v[8:11], a[136:139], v[64:79]
    v_cvt_pk_bf16_f32 v176, v96, v97
    v_cvt_pk_bf16_f32 v177, v98, v99
    v_cvt_pk_bf16_f32 v178, v100, v101
    v_cvt_pk_bf16_f32 v179, v102, v103
    v_cvt_pk_bf16_f32 v180, v104, v105
    v_mfma_f32_32x32x16_bf16 v[64:79], v[12:15], a[140:143], v[64:79]
    v_cvt_pk_bf16_f32 v181, v106, v107
    v_cvt_pk_bf16_f32 v182, v108, v109
    v_cvt_pk_bf16_f32 v183, v110, v111
    v_cvt_pk_bf16_f32 v184, v112, v113
    v_cvt_pk_bf16_f32 v185, v114, v115
    v_mfma_f32_32x32x16_bf16 v[64:79], v[16:19], a[144:147], v[64:79]
    v_cvt_pk_bf16_f32 v186, v116, v117
    v_cvt_pk_bf16_f32 v187, v118, v119
    v_cvt_pk_bf16_f32 v188, v120, v121
    v_cvt_pk_bf16_f32 v189, v122, v123
    v_cvt_pk_bf16_f32 v190, v124, v125
    v_mfma_f32_32x32x16_bf16 v[64:79], v[20:23], a[148:151], v[64:79]
    v_cvt_pk_bf16_f32 v191, v126, v127
    v_mfma_f32_32x32x16_bf16 v[64:79], v[24:27], a[152:155], v[64:79]
    v_mfma_f32_32x32x16_bf16 v[64:79], v[28:31], a[156:159], v[64:79]
    v_mfma_f32_32x32x16_bf16 v[80:95], v[0:3], a[160:163], 0
    v_mfma_f32_32x32x16_bf16 v[80:95], v[4:7], a[164:167], v[80:95]
    v_mfma_f32_32x32x16_bf16 v[80:95], v[8:11], a[168:171], v[80:95]
    v_mfma_f32_32x32x16_bf16 v[80:95], v[12:15], a[172:175], v[80:95]
    v_mfma_f32_32x32x16_bf16 v[80:95], v[16:19], a[176:179], v[80:95]
    v_mfma_f32_32x32x16_bf16 v[80:95], v[20:23], a[180:183], v[80:95]
    v_mfma_f32_32x32x16_bf16 v[80:95], v[24:27], a[184:187], v[80:95]
    v_mfma_f32_32x32x16_bf16 v[80:95], v[28:31], a[188:191], v[80:95]
    v_mfma_f32_32x32x16_bf16 v[96:111], v[176:179], v[160:163], 0
    s_nop 2
    v_cvt_pk_bf16_f32 v192, v64, v65
    v_cvt_pk_bf16_f32 v193, v66, v67
    v_cvt_pk_bf16_f32 v194, v68, v69
    v_cvt_pk_bf16_f32 v195, v70, v71
    v_cvt_pk_bf16_f32 v196, v72, v73
    v_mfma_f32_32x32x16_bf16 v[96:111], v[180:183], v[164:167], v[96:111]
    v_cvt_pk_bf16_f32 v197, v74, v75
    v_cvt_pk_bf16_f32 v198, v76, v77
    v_cvt_pk_bf16_f32 v199, v78, v79
    v_cvt_pk_bf16_f32 v200, v80, v81
    v_cvt_pk_bf16_f32 v201, v82, v83
    v_mfma_f32_32x32x16_bf16 v[96:111], v[184:187], v[168:171], v[96:111]
    v_cvt_pk_bf16_f32 v202, v84, v85
    v_cvt_pk_bf16_f32 v203, v86, v87
    v_cvt_pk_bf16_f32 v204, v88, v89
    v_cvt_pk_bf16_f32 v205, v90, v91
    v_cvt_pk_bf16_f32 v206, v92, v93
    v_mfma_f32_32x32x16_bf16 v[96:111], v[188:191], v[172:175], v[96:111]
    v_cvt_pk_bf16_f32 v207, v94, v95
    v_mfma_f32_32x32x16_bf16 v[128:143], a[192:195], v[0:3], 0
    v_mfma_f32_32x32x16_bf16 v[128:143], a[196:199], v[4:7], v[128:143]
    s_nop 8
    v_cndmask_b32 v108, v108, v234, s[40:41]
    v_cndmask_b32 v109, v109, v234, s[40:41]
    v_max3_f32 v235, v96, v97, v98
    v_max3_f32 v236, v99, v100, v101
    v_max3_f32 v237, v102, v103, v104
    v_mfma_f32_32x32x16_bf16 v[128:143], a[200:203], v[8:11], v[128:143]
    v_max3_f32 v238, v105, v106, v107
    v_max3_f32 v235, v235, v108, v109
    v_max3_f32 v236, v236, v237, v238
    v_max_f32 v239, v235, v236
    v_mov_b32 v237, v239
    v_mfma_f32_32x32x16_bf16 v[128:143], a[204:207], v[12:15], v[128:143]
    s_nop 0
    v_permlane32_swap_b32 v239, v237
    v_max_f32 v239, v239, v237
    v_mul_f32 v239, s42, v239
    v_fma_f32 v96, v96, s42, -v239
    v_exp_f32 v96, v96
    v_mfma_f32_32x32x16_bf16 v[128:143], a[208:211], v[16:19], v[128:143]
    v_fma_f32 v97, v97, s42, -v239
    v_exp_f32 v97, v97
    v_fma_f32 v98, v98, s42, -v239
    v_exp_f32 v98, v98
    v_mfma_f32_32x32x16_bf16 v[128:143], a[212:215], v[20:23], v[128:143]
    v_fma_f32 v99, v99, s42, -v239
    v_exp_f32 v99, v99
    v_fma_f32 v100, v100, s42, -v239
    v_exp_f32 v100, v100
    v_mfma_f32_32x32x16_bf16 v[128:143], a[216:219], v[24:27], v[128:143]
    v_fma_f32 v101, v101, s42, -v239
    v_exp_f32 v101, v101
    v_fma_f32 v102, v102, s42, -v239
    v_exp_f32 v102, v102
    v_mfma_f32_32x32x16_bf16 v[128:143], a[220:223], v[28:31], v[128:143]
    v_fma_f32 v103, v103, s42, -v239
    v_exp_f32 v103, v103
    v_fma_f32 v104, v104, s42, -v239
    v_exp_f32 v104, v104
    v_mfma_f32_32x32x16_bf16 v[144:159], a[224:227], v[0:3], 0
    v_fma_f32 v105, v105, s42, -v239
    v_exp_f32 v105, v105
    v_fma_f32 v106, v106, s42, -v239
    v_exp_f32 v106, v106
    v_mfma_f32_32x32x16_bf16 v[144:159], a[228:231], v[4:7], v[144:159]
    v_fma_f32 v107, v107, s42, -v239
    v_exp_f32 v107, v107
    v_fma_f32 v108, v108, s42, -v239
    v_exp_f32 v108, v108
    v_mfma_f32_32x32x16_bf16 v[144:159], a[232:235], v[8:11], v[144:159]
    v_fma_f32 v109, v109, s42, -v239
    v_exp_f32 v109, v109
    v_add_f32 v235, v96, v97
    v_add_f32 v236, v98, v99
    v_mfma_f32_32x32x16_bf16 v[144:159], a[236:239], v[12:15], v[144:159]
    v_add_f32 v237, v100, v101
    v_add_f32 v238, v102, v103
    v_add_f32 v235, v235, v104
    v_add_f32 v236, v236, v105
    v_add_f32 v237, v237, v106
    v_mfma_f32_32x32x16_bf16 v[144:159], a[240:243], v[16:19], v[144:159]
    v_add_f32 v238, v238, v107
    v_add_f32 v235, v235, v108
    v_add_f32 v236, v236, v109
    v_add_f32 v235, v235, v237
    v_add_f32 v236, v236, v238
    v_mfma_f32_32x32x16_bf16 v[144:159], a[244:247], v[20:23], v[144:159]
    v_add_f32 v240, v235, v236
    v_mov_b32 v237, v240
    s_nop 1
    v_permlane32_swap_b32 v240, v237
    v_add_f32 v240, v240, v237
    v_rcp_f32 v240, v240
    v_mfma_f32_32x32x16_bf16 v[144:159], a[248:251], v[24:27], v[144:159]
    v_mul_f32 v96, v240, v96
    v_mul_f32 v97, v240, v97
    v_mul_f32 v98, v240, v98
    v_mul_f32 v99, v240, v99
    v_mul_f32 v100, v240, v100
    v_mfma_f32_32x32x16_bf16 v[144:159], a[252:255], v[28:31], v[144:159]
    v_mul_f32 v101, v240, v101
    v_mul_f32 v102, v240, v102
    v_mul_f32 v103, v240, v103
    v_mul_f32 v104, v240, v104
    v_mul_f32 v105, v240, v105
    s_waitcnt vmcnt(4)
    v_mfma_f32_32x32x16_bf16 v[64:79], a[0:3], v[32:35], 0
    v_mul_f32 v106, v240, v106
    v_mul_f32 v107, v240, v107
    v_mul_f32 v108, v240, v108
    v_mul_f32 v109, v240, v109
    v_cvt_pk_bf16_f32 v208, v96, v97
    v_mfma_f32_32x32x16_bf16 v[64:79], a[4:7], v[36:39], v[64:79]
    v_cvt_pk_bf16_f32 v209, v98, v99
    v_cvt_pk_bf16_f32 v210, v100, v101
    v_cvt_pk_bf16_f32 v211, v102, v103
    v_cvt_pk_bf16_f32 v212, v104, v105
    v_cvt_pk_bf16_f32 v213, v106, v107
    v_mfma_f32_32x32x16_bf16 v[64:79], a[8:11], v[40:43], v[64:79]
    v_cvt_pk_bf16_f32 v214, v108, v109
    v_mfma_f32_32x32x16_bf16 v[64:79], a[12:15], v[44:47], v[64:79]
    v_mfma_f32_32x32x16_bf16 v[64:79], a[16:19], v[48:51], v[64:79]
    v_mfma_f32_32x32x16_bf16 v[64:79], a[20:23], v[52:55], v[64:79]
    v_mfma_f32_32x32x16_bf16 v[64:79], a[24:27], v[56:59], v[64:79]
    v_mfma_f32_32x32x16_bf16 v[64:79], a[28:31], v[60:63], v[64:79]
    v_mfma_f32_32x32x16_bf16 v[80:95], a[32:35], v[32:35], 0
    v_mfma_f32_32x32x16_bf16 v[80:95], a[36:39], v[36:39], v[80:95]
    v_mfma_f32_32x32x16_bf16 v[80:95], a[40:43], v[40:43], v[80:95]
    v_mfma_f32_32x32x16_bf16 v[80:95], a[44:47], v[44:47], v[80:95]
    v_mfma_f32_32x32x16_bf16 v[80:95], a[48:51], v[48:51], v[80:95]
    v_mfma_f32_32x32x16_bf16 v[80:95], a[52:55], v[52:55], v[80:95]
    v_mfma_f32_32x32x16_bf16 v[80:95], a[56:59], v[56:59], v[80:95]
    v_mfma_f32_32x32x16_bf16 v[80:95], a[60:63], v[60:63], v[80:95]
    v_mfma_f32_32x32x16_bf16 v[128:143], v[192:195], v[208:211], v[128:143]
    v_mfma_f32_32x32x16_bf16 v[128:143], v[196:199], v[212:215], v[128:143]
    v_mfma_f32_32x32x16_bf16 v[144:159], v[200:203], v[208:211], v[144:159]
    v_mfma_f32_32x32x16_bf16 v[144:159], v[204:207], v[212:215], v[144:159]
    s_mov_b32 s52, s50
    s_mov_b32 s50, s51
    s_add_u32 s51, s51, 6656
    v_mfma_f32_32x32x16_bf16 v[96:111], a[64:67], v[32:35], 0
    v_mfma_f32_32x32x16_bf16 v[96:111], a[68:71], v[36:39], v[96:111]
    v_mfma_f32_32x32x16_bf16 v[96:111], a[72:75], v[40:43], v[96:111]
    buffer_load_dwordx4 v[0:3], v232, s[8:11], s51 offen offset:0
    buffer_load_dwordx4 v[4:7], v232, s[8:11], s51 offen offset:32
    buffer_load_dwordx4 v[8:11], v232, s[8:11], s51 offen offset:64
    buffer_load_dwordx4 v[12:15], v232, s[8:11], s51 offen offset:96
    buffer_load_dwordx4 v[16:19], v232, s[8:11], s51 offen offset:128
    v_mfma_f32_32x32x16_bf16 v[96:111], a[76:79], v[44:47], v[96:111]
    buffer_load_dwordx4 v[20:23], v232, s[8:11], s51 offen offset:160
    buffer_load_dwordx4 v[24:27], v232, s[8:11], s51 offen offset:192
    buffer_load_dwordx4 v[28:31], v232, s[8:11], s51 offen offset:224
    v_cvt_pk_bf16_f32 v160, v64, v65
    v_cvt_pk_bf16_f32 v161, v66, v67
    v_mfma_f32_32x32x16_bf16 v[96:111], a[80:83], v[48:51], v[96:111]
    v_cvt_pk_bf16_f32 v162, v68, v69
    v_cvt_pk_bf16_f32 v163, v70, v71
    v_cvt_pk_bf16_f32 v164, v72, v73
    v_cvt_pk_bf16_f32 v165, v74, v75
    v_cvt_pk_bf16_f32 v166, v76, v77
    v_mfma_f32_32x32x16_bf16 v[96:111], a[84:87], v[52:55], v[96:111]
    v_cvt_pk_bf16_f32 v167, v78, v79
    v_cvt_pk_bf16_f32 v168, v80, v81
    v_cvt_pk_bf16_f32 v169, v82, v83
    v_cvt_pk_bf16_f32 v170, v84, v85
    v_cvt_pk_bf16_f32 v171, v86, v87
    v_mfma_f32_32x32x16_bf16 v[96:111], a[88:91], v[56:59], v[96:111]
    v_cvt_pk_bf16_f32 v172, v88, v89
    v_cvt_pk_bf16_f32 v173, v90, v91
    v_cvt_pk_bf16_f32 v174, v92, v93
    v_cvt_pk_bf16_f32 v175, v94, v95
    v_cvt_pk_bf16_f32 v216, v128, v129
    v_mfma_f32_32x32x16_bf16 v[96:111], a[92:95], v[60:63], v[96:111]
    v_cvt_pk_bf16_f32 v217, v130, v131
    v_cvt_pk_bf16_f32 v218, v132, v133
    v_cvt_pk_bf16_f32 v219, v134, v135
    v_cvt_pk_bf16_f32 v220, v136, v137
    v_cvt_pk_bf16_f32 v221, v138, v139
    v_mfma_f32_32x32x16_bf16 v[112:127], a[96:99], v[32:35], 0
    v_cvt_pk_bf16_f32 v222, v140, v141
    v_cvt_pk_bf16_f32 v223, v142, v143
    v_cvt_pk_bf16_f32 v224, v144, v145
    v_cvt_pk_bf16_f32 v225, v146, v147
    v_cvt_pk_bf16_f32 v226, v148, v149
    v_mfma_f32_32x32x16_bf16 v[112:127], a[100:103], v[36:39], v[112:127]
    v_cvt_pk_bf16_f32 v227, v150, v151
    v_cvt_pk_bf16_f32 v228, v152, v153
    v_cvt_pk_bf16_f32 v229, v154, v155
    v_cvt_pk_bf16_f32 v230, v156, v157
    v_cvt_pk_bf16_f32 v231, v158, v159
    v_mfma_f32_32x32x16_bf16 v[112:127], a[104:107], v[40:43], v[112:127]
    v_pk_max_i16 v216, v216, 0
    v_pk_max_i16 v217, v217, 0
    v_pk_max_i16 v218, v218, 0
    v_pk_max_i16 v219, v219, 0
    v_pk_max_i16 v220, v220, 0
    v_mfma_f32_32x32x16_bf16 v[112:127], a[108:111], v[44:47], v[112:127]
    v_pk_max_i16 v221, v221, 0
    v_pk_max_i16 v222, v222, 0
    v_pk_max_i16 v223, v223, 0
    v_pk_max_i16 v224, v224, 0
    v_pk_max_i16 v225, v225, 0
    v_mfma_f32_32x32x16_bf16 v[112:127], a[112:115], v[48:51], v[112:127]
    v_pk_max_i16 v226, v226, 0
    v_pk_max_i16 v227, v227, 0
    v_pk_max_i16 v228, v228, 0
    v_pk_max_i16 v229, v229, 0
    v_pk_max_i16 v230, v230, 0
    v_mfma_f32_32x32x16_bf16 v[112:127], a[116:119], v[52:55], v[112:127]
    v_pk_max_i16 v231, v231, 0
    v_permlane32_swap_b32 v216, v218
    v_permlane32_swap_b32 v217, v219
    buffer_store_dwordx4 v[216:219], v233, s[24:27], s52 offen offset:0
    v_permlane32_swap_b32 v220, v222
    v_mfma_f32_32x32x16_bf16 v[112:127], a[120:123], v[56:59], v[112:127]
    v_permlane32_swap_b32 v221, v223
    buffer_store_dwordx4 v[220:223], v233, s[24:27], s52 offen offset:32
    v_permlane32_swap_b32 v224, v226
    v_permlane32_swap_b32 v225, v227
    buffer_store_dwordx4 v[224:227], v233, s[24:27], s52 offen offset:64
    v_mfma_f32_32x32x16_bf16 v[112:127], a[124:127], v[60:63], v[112:127]
    v_permlane32_swap_b32 v228, v230
    v_permlane32_swap_b32 v229, v231
    buffer_store_dwordx4 v[228:231], v233, s[24:27], s52 offen offset:96
    v_mfma_f32_32x32x16_bf16 v[64:79], v[32:35], a[128:131], 0
    v_mfma_f32_32x32x16_bf16 v[64:79], v[36:39], a[132:135], v[64:79]
    v_mfma_f32_32x32x16_bf16 v[64:79], v[40:43], a[136:139], v[64:79]
    v_cvt_pk_bf16_f32 v176, v96, v97
    v_cvt_pk_bf16_f32 v177, v98, v99
    v_cvt_pk_bf16_f32 v178, v100, v101
    v_cvt_pk_bf16_f32 v179, v102, v103
    v_cvt_pk_bf16_f32 v180, v104, v105
    v_mfma_f32_32x32x16_bf16 v[64:79], v[44:47], a[140:143], v[64:79]
    v_cvt_pk_bf16_f32 v181, v106, v107
    v_cvt_pk_bf16_f32 v182, v108, v109
    v_cvt_pk_bf16_f32 v183, v110, v111
    v_cvt_pk_bf16_f32 v184, v112, v113
    v_cvt_pk_bf16_f32 v185, v114, v115
    v_mfma_f32_32x32x16_bf16 v[64:79], v[48:51], a[144:147], v[64:79]
    v_cvt_pk_bf16_f32 v186, v116, v117
    v_cvt_pk_bf16_f32 v187, v118, v119
    v_cvt_pk_bf16_f32 v188, v120, v121
    v_cvt_pk_bf16_f32 v189, v122, v123
    v_cvt_pk_bf16_f32 v190, v124, v125
    v_mfma_f32_32x32x16_bf16 v[64:79], v[52:55], a[148:151], v[64:79]
    v_cvt_pk_bf16_f32 v191, v126, v127
    v_mfma_f32_32x32x16_bf16 v[64:79], v[56:59], a[152:155], v[64:79]
    v_mfma_f32_32x32x16_bf16 v[64:79], v[60:63], a[156:159], v[64:79]
    v_mfma_f32_32x32x16_bf16 v[80:95], v[32:35], a[160:163], 0
    v_mfma_f32_32x32x16_bf16 v[80:95], v[36:39], a[164:167], v[80:95]
    v_mfma_f32_32x32x16_bf16 v[80:95], v[40:43], a[168:171], v[80:95]
    v_mfma_f32_32x32x16_bf16 v[80:95], v[44:47], a[172:175], v[80:95]
    v_mfma_f32_32x32x16_bf16 v[80:95], v[48:51], a[176:179], v[80:95]
    v_mfma_f32_32x32x16_bf16 v[80:95], v[52:55], a[180:183], v[80:95]
    v_mfma_f32_32x32x16_bf16 v[80:95], v[56:59], a[184:187], v[80:95]
    v_mfma_f32_32x32x16_bf16 v[80:95], v[60:63], a[188:191], v[80:95]
    v_mfma_f32_32x32x16_bf16 v[96:111], v[176:179], v[160:163], 0
    s_nop 2
    v_cvt_pk_bf16_f32 v192, v64, v65
    v_cvt_pk_bf16_f32 v193, v66, v67
    v_cvt_pk_bf16_f32 v194, v68, v69
    v_cvt_pk_bf16_f32 v195, v70, v71
    v_cvt_pk_bf16_f32 v196, v72, v73
    v_mfma_f32_32x32x16_bf16 v[96:111], v[180:183], v[164:167], v[96:111]
    v_cvt_pk_bf16_f32 v197, v74, v75
    v_cvt_pk_bf16_f32 v198, v76, v77
    v_cvt_pk_bf16_f32 v199, v78, v79
    v_cvt_pk_bf16_f32 v200, v80, v81
    v_cvt_pk_bf16_f32 v201, v82, v83
    v_mfma_f32_32x32x16_bf16 v[96:111], v[184:187], v[168:171], v[96:111]
    v_cvt_pk_bf16_f32 v202, v84, v85
    v_cvt_pk_bf16_f32 v203, v86, v87
    v_cvt_pk_bf16_f32 v204, v88, v89
    v_cvt_pk_bf16_f32 v205, v90, v91
    v_cvt_pk_bf16_f32 v206, v92, v93
    v_mfma_f32_32x32x16_bf16 v[96:111], v[188:191], v[172:175], v[96:111]
    v_cvt_pk_bf16_f32 v207, v94, v95
    v_mfma_f32_32x32x16_bf16 v[128:143], a[192:195], v[32:35], 0
    v_mfma_f32_32x32x16_bf16 v[128:143], a[196:199], v[36:39], v[128:143]
    s_nop 8
    v_cndmask_b32 v108, v108, v234, s[40:41]
    v_cndmask_b32 v109, v109, v234, s[40:41]
    v_max3_f32 v235, v96, v97, v98
    v_max3_f32 v236, v99, v100, v101
    v_max3_f32 v237, v102, v103, v104
    v_mfma_f32_32x32x16_bf16 v[128:143], a[200:203], v[40:43], v[128:143]
    v_max3_f32 v238, v105, v106, v107
    v_max3_f32 v235, v235, v108, v109
    v_max3_f32 v236, v236, v237, v238
    v_max_f32 v239, v235, v236
    v_mov_b32 v237, v239
    v_mfma_f32_32x32x16_bf16 v[128:143], a[204:207], v[44:47], v[128:143]
    s_nop 0
    v_permlane32_swap_b32 v239, v237
    v_max_f32 v239, v239, v237
    v_mul_f32 v239, s42, v239
    v_fma_f32 v96, v96, s42, -v239
    v_exp_f32 v96, v96
    v_mfma_f32_32x32x16_bf16 v[128:143], a[208:211], v[48:51], v[128:143]
    v_fma_f32 v97, v97, s42, -v239
    v_exp_f32 v97, v97
    v_fma_f32 v98, v98, s42, -v239
    v_exp_f32 v98, v98
    v_mfma_f32_32x32x16_bf16 v[128:143], a[212:215], v[52:55], v[128:143]
    v_fma_f32 v99, v99, s42, -v239
    v_exp_f32 v99, v99
    v_fma_f32 v100, v100, s42, -v239
    v_exp_f32 v100, v100
    v_mfma_f32_32x32x16_bf16 v[128:143], a[216:219], v[56:59], v[128:143]
    v_fma_f32 v101, v101, s42, -v239
    v_exp_f32 v101, v101
    v_fma_f32 v102, v102, s42, -v239
    v_exp_f32 v102, v102
    v_mfma_f32_32x32x16_bf16 v[128:143], a[220:223], v[60:63], v[128:143]
    v_fma_f32 v103, v103, s42, -v239
    v_exp_f32 v103, v103
    v_fma_f32 v104, v104, s42, -v239
    v_exp_f32 v104, v104
    v_mfma_f32_32x32x16_bf16 v[144:159], a[224:227], v[32:35], 0
    v_fma_f32 v105, v105, s42, -v239
    v_exp_f32 v105, v105
    v_fma_f32 v106, v106, s42, -v239
    v_exp_f32 v106, v106
    v_mfma_f32_32x32x16_bf16 v[144:159], a[228:231], v[36:39], v[144:159]
    v_fma_f32 v107, v107, s42, -v239
    v_exp_f32 v107, v107
    v_fma_f32 v108, v108, s42, -v239
    v_exp_f32 v108, v108
    v_mfma_f32_32x32x16_bf16 v[144:159], a[232:235], v[40:43], v[144:159]
    v_fma_f32 v109, v109, s42, -v239
    v_exp_f32 v109, v109
    v_add_f32 v235, v96, v97
    v_add_f32 v236, v98, v99
    v_mfma_f32_32x32x16_bf16 v[144:159], a[236:239], v[44:47], v[144:159]
    v_add_f32 v237, v100, v101
    v_add_f32 v238, v102, v103
    v_add_f32 v235, v235, v104
    v_add_f32 v236, v236, v105
    v_add_f32 v237, v237, v106
    v_mfma_f32_32x32x16_bf16 v[144:159], a[240:243], v[48:51], v[144:159]
    v_add_f32 v238, v238, v107
    v_add_f32 v235, v235, v108
    v_add_f32 v236, v236, v109
    v_add_f32 v235, v235, v237
    v_add_f32 v236, v236, v238
    v_mfma_f32_32x32x16_bf16 v[144:159], a[244:247], v[52:55], v[144:159]
    v_add_f32 v240, v235, v236
    v_mov_b32 v237, v240
    s_nop 1
    v_permlane32_swap_b32 v240, v237
    v_add_f32 v240, v240, v237
    v_rcp_f32 v240, v240
    v_mfma_f32_32x32x16_bf16 v[144:159], a[248:251], v[56:59], v[144:159]
    v_mul_f32 v96, v240, v96
    v_mul_f32 v97, v240, v97
    v_mul_f32 v98, v240, v98
    v_mul_f32 v99, v240, v99
    v_mul_f32 v100, v240, v100
    v_mfma_f32_32x32x16_bf16 v[144:159], a[252:255], v[60:63], v[144:159]
    v_mul_f32 v101, v240, v101
    v_mul_f32 v102, v240, v102
    v_mul_f32 v103, v240, v103
    v_mul_f32 v104, v240, v104
    v_mul_f32 v105, v240, v105
    s_waitcnt vmcnt(4)
    v_mfma_f32_32x32x16_bf16 v[64:79], a[0:3], v[0:3], 0
    v_mul_f32 v106, v240, v106
    v_mul_f32 v107, v240, v107
    v_mul_f32 v108, v240, v108
    v_mul_f32 v109, v240, v109
    v_cvt_pk_bf16_f32 v208, v96, v97
    v_mfma_f32_32x32x16_bf16 v[64:79], a[4:7], v[4:7], v[64:79]
    v_cvt_pk_bf16_f32 v209, v98, v99
    v_cvt_pk_bf16_f32 v210, v100, v101
    v_cvt_pk_bf16_f32 v211, v102, v103
    v_cvt_pk_bf16_f32 v212, v104, v105
    v_cvt_pk_bf16_f32 v213, v106, v107
    v_mfma_f32_32x32x16_bf16 v[64:79], a[8:11], v[8:11], v[64:79]
    v_cvt_pk_bf16_f32 v214, v108, v109
    v_mfma_f32_32x32x16_bf16 v[64:79], a[12:15], v[12:15], v[64:79]
    v_mfma_f32_32x32x16_bf16 v[64:79], a[16:19], v[16:19], v[64:79]
    v_mfma_f32_32x32x16_bf16 v[64:79], a[20:23], v[20:23], v[64:79]
    v_mfma_f32_32x32x16_bf16 v[64:79], a[24:27], v[24:27], v[64:79]
    v_mfma_f32_32x32x16_bf16 v[64:79], a[28:31], v[28:31], v[64:79]
    v_mfma_f32_32x32x16_bf16 v[80:95], a[32:35], v[0:3], 0
    v_mfma_f32_32x32x16_bf16 v[80:95], a[36:39], v[4:7], v[80:95]
    v_mfma_f32_32x32x16_bf16 v[80:95], a[40:43], v[8:11], v[80:95]
    v_mfma_f32_32x32x16_bf16 v[80:95], a[44:47], v[12:15], v[80:95]
    v_mfma_f32_32x32x16_bf16 v[80:95], a[48:51], v[16:19], v[80:95]
    v_mfma_f32_32x32x16_bf16 v[80:95], a[52:55], v[20:23], v[80:95]
    v_mfma_f32_32x32x16_bf16 v[80:95], a[56:59], v[24:27], v[80:95]
    v_mfma_f32_32x32x16_bf16 v[80:95], a[60:63], v[28:31], v[80:95]
    v_mfma_f32_32x32x16_bf16 v[128:143], v[192:195], v[208:211], v[128:143]
    v_mfma_f32_32x32x16_bf16 v[128:143], v[196:199], v[212:215], v[128:143]
    v_mfma_f32_32x32x16_bf16 v[144:159], v[200:203], v[208:211], v[144:159]
    v_mfma_f32_32x32x16_bf16 v[144:159], v[204:207], v[212:215], v[144:159]
    s_mov_b32 s52, s50
    s_mov_b32 s50, s51
    s_add_u32 s51, s51, 6656
    s_sub_u32 s53, s53, 1
    s_cmp_lg_u32 s53, 0
    s_cbranch_scc1 L_loop
    s_nop 3
    v_cvt_pk_bf16_f32 v216, v128, v129
    v_cvt_pk_bf16_f32 v217, v130, v131
    v_cvt_pk_bf16_f32 v218, v132, v133
    v_cvt_pk_bf16_f32 v219, v134, v135
    v_cvt_pk_bf16_f32 v220, v136, v137
    v_cvt_pk_bf16_f32 v221, v138, v139
    v_cvt_pk_bf16_f32 v222, v140, v141
    v_cvt_pk_bf16_f32 v223, v142, v143
    v_cvt_pk_bf16_f32 v224, v144, v145
    v_cvt_pk_bf16_f32 v225, v146, v147
    v_cvt_pk_bf16_f32 v226, v148, v149
    v_cvt_pk_bf16_f32 v227, v150, v151
    v_cvt_pk_bf16_f32 v228, v152, v153
    v_cvt_pk_bf16_f32 v229, v154, v155
    v_cvt_pk_bf16_f32 v230, v156, v157
    v_cvt_pk_bf16_f32 v231, v158, v159
    v_pk_max_i16 v216, v216, 0
    v_pk_max_i16 v217, v217, 0
    v_pk_max_i16 v218, v218, 0
    v_pk_max_i16 v219, v219, 0
    v_pk_max_i16 v220, v220, 0
    v_pk_max_i16 v221, v221, 0
    v_pk_max_i16 v222, v222, 0
    v_pk_max_i16 v223, v223, 0
    v_pk_max_i16 v224, v224, 0
    v_pk_max_i16 v225, v225, 0
    v_pk_max_i16 v226, v226, 0
    v_pk_max_i16 v227, v227, 0
    v_pk_max_i16 v228, v228, 0
    v_pk_max_i16 v229, v229, 0
    v_pk_max_i16 v230, v230, 0
    v_pk_max_i16 v231, v231, 0
    v_permlane32_swap_b32 v216, v218
    v_permlane32_swap_b32 v217, v219
    buffer_store_dwordx4 v[216:219], v233, s[24:27], s52 offen offset:0
    v_permlane32_swap_b32 v220, v222
    v_permlane32_swap_b32 v221, v223
    buffer_store_dwordx4 v[220:223], v233, s[24:27], s52 offen offset:32
    v_permlane32_swap_b32 v224, v226
    v_permlane32_swap_b32 v225, v227
    buffer_store_dwordx4 v[224:227], v233, s[24:27], s52 offen offset:64
    v_permlane32_swap_b32 v228, v230
    v_permlane32_swap_b32 v229, v231
    buffer_store_dwordx4 v[228:231], v233, s[24:27], s52 offen offset:96
L_done:
    s_endpgm
.section .rodata,"a"
.p2align 6
.amdhsa_kernel standalone__attention_interact_autoint__recsys_kernel
  .amdhsa_next_free_vgpr 512
  .amdhsa_next_free_sgpr 102
  .amdhsa_accum_offset 256
  .amdhsa_group_segment_fixed_size 0
  .amdhsa_kernarg_size 64
  .amdhsa_user_sgpr_count 2
  .amdhsa_user_sgpr_kernarg_segment_ptr 1
  .amdhsa_system_sgpr_workgroup_id_x 1
.end_amdhsa_kernel
```
